```python
import torch

def _softmax(x, axis=-1):
    return torch.softmax(x, dim=axis)
def _gelu(x):
    return torch.nn.functional.gelu(x, approximate="tanh")
def _silu(x):
    return torch.nn.functional.silu(x)
def _sigmoid(x):
    return torch.sigmoid(x)
def _layernorm(x, axis=-1, eps=1e-5):
    m = x.mean(dim=axis, keepdim=True)
    v = x.var(dim=axis, keepdim=True, unbiased=False)
    return (x - m) / torch.sqrt(v + eps)
def _scatter_add(tgt, idx, src, axis=0):
    return tgt.clone().index_add_(axis, idx, src)
def _segment_sum(src, seg, n):
    out = torch.zeros((n,) + src.shape[1:], dtype=src.dtype)
    return out.index_add_(0, seg, src)
def _pad(x, pw):
    flat = tuple(v for pair in reversed(pw) for v in pair)
    return torch.nn.functional.pad(x, flat)

kernel_name = 'standalone__deepnorm__sampling'

def setup_inputs():

    _w = (lambda a: (lambda t: t.to(torch.bfloat16) if t.is_floating_point() else t)(torch.as_tensor(a)))
    B, S, D = 1024, 16, 640
    return {
        "x": _w((lambda *s: torch.randn(*s, dtype=torch.bfloat16) * 0.05)(B, S, D)),
        "f": _w((lambda *s: torch.randn(*s, dtype=torch.bfloat16) * 0.05)(B, S, D)),
        "g": _w((lambda *s: torch.randn(*s, dtype=torch.bfloat16) * 0.05)(D) + 1.0),
        "b": _w((lambda *s: torch.randn(*s, dtype=torch.bfloat16) * 0.4)(D)),
        "alpha": _w(float(2.0)),
    }

def reference(x, f, g, b, alpha):
    return _layernorm(alpha * x + f, axis=-1) * g + b
```

```asm
; @launch grid=(256,1,1) block=(1024,1,1) lds=5120
.amdgcn_target "amdgcn-amd-amdhsa--gfx950"
.text
.globl standalone__deepnorm__sampling_kernel
.p2align 13
.p2align 8
.type standalone__deepnorm__sampling_kernel,@function
standalone__deepnorm__sampling_kernel:
    s_load_dwordx16 s[4:19], s[0:1], 0
    s_cmpk_ge_u32 s2, 256
    s_cbranch_scc1 L_end
    v_readfirstlane_b32 s23, v0
    s_mul_i32 s3, s2, 5120
    v_lshrrev_b32 v1, 4, v0
    v_lshlrev_b32 v2, 4, v0
    v_lshl_add_u32 v1, v1, 10, v2
    s_mul_i32 s25, s23, 20400
    s_add_u32 s3, s3, s25
    v_add_u32 v1, s3, v1
    s_cmpk_ge_u32 s23, 768
    s_cbranch_scc1 L_tramp
    s_cmpk_ge_u32 s23, 256
    s_cbranch_scc1 L_wait
    v_min_u32 v6, 0x9f, v0
    v_lshlrev_b32 v3, 3, v6
    s_waitcnt lgkmcnt(0)
    s_load_dword s20, s[12:13], 0
    global_load_dwordx2 v[48:49], v3, s[8:9]
    global_load_dwordx2 v[50:51], v3, s[10:11]
L_ld:
    global_load_dwordx4 v[8:11], v1, s[4:5] offset:0 nt
    global_load_dwordx4 v[12:15], v1, s[4:5] offset:256 nt
    global_load_dwordx4 v[16:19], v1, s[4:5] offset:512 nt
    global_load_dwordx4 v[20:23], v1, s[4:5] offset:768 nt
    global_load_dwordx4 v[24:27], v1, s[4:5] offset:1024 nt
    global_load_dwordx4 v[28:31], v1, s[6:7] offset:0 nt
    global_load_dwordx4 v[32:35], v1, s[6:7] offset:256 nt
    global_load_dwordx4 v[36:39], v1, s[6:7] offset:512 nt
    global_load_dwordx4 v[40:43], v1, s[6:7] offset:768 nt
    global_load_dwordx4 v[44:47], v1, s[6:7] offset:1024 nt
    s_mov_b32 s24, 0
L_ldone:
    s_max_u32 s26, s23, 0x100
    s_branch L_postc
L_post:
    s_barrier
    s_add_u32 s26, s26, 64
L_postc:
    s_cmpk_lt_u32 s26, 768
    s_cbranch_scc1 L_post
    s_mov_b32 s22, 0xffff0000
    v_and_b32 v2, 0xf0, v2
    s_cmpk_lt_u32 s23, 256
    s_cbranch_scc1 L_stage
L_staged:
    s_waitcnt lgkmcnt(0)
    s_lshl_b32 s20, s20, 16
L_pass:
    s_cmpk_lt_u32 s23, 768
    s_cbranch_scc1 L_early
    s_waitcnt vmcnt(6)
    s_barrier
L_early:
    s_waitcnt vmcnt(4)
    v_lshlrev_b32 v88, 16, v8
    v_and_b32 v89, s22, v8
    v_lshlrev_b32 v90, 16, v28
    v_and_b32 v91, s22, v28
    v_lshlrev_b32 v92, 16, v9
    v_and_b32 v93, s22, v9
    v_lshlrev_b32 v28, 16, v29
    v_and_b32 v29, s22, v29
    v_pk_fma_f32 v[8:9], v[88:89], s[20:21], v[90:91] op_sel_hi:[1,0,1]
    v_pk_fma_f32 v[28:29], v[92:93], s[20:21], v[28:29] op_sel_hi:[1,0,1]
    v_pk_add_f32 v[4:5], v[8:9], v[28:29]
    v_lshlrev_b32 v88, 16, v10
    v_and_b32 v89, s22, v10
    v_lshlrev_b32 v90, 16, v30
    v_and_b32 v91, s22, v30
    v_lshlrev_b32 v92, 16, v11
    v_and_b32 v93, s22, v11
    v_lshlrev_b32 v30, 16, v31
    v_and_b32 v31, s22, v31
    v_pk_fma_f32 v[10:11], v[88:89], s[20:21], v[90:91] op_sel_hi:[1,0,1]
    v_pk_fma_f32 v[30:31], v[92:93], s[20:21], v[30:31] op_sel_hi:[1,0,1]
    v_pk_add_f32 v[4:5], v[4:5], v[10:11]
    v_pk_add_f32 v[4:5], v[4:5], v[30:31]
    s_waitcnt vmcnt(3)
    v_lshlrev_b32 v88, 16, v12
    v_and_b32 v89, s22, v12
    v_lshlrev_b32 v90, 16, v32
    v_and_b32 v91, s22, v32
    v_lshlrev_b32 v92, 16, v13
    v_and_b32 v93, s22, v13
    v_lshlrev_b32 v32, 16, v33
    v_and_b32 v33, s22, v33
    v_pk_fma_f32 v[12:13], v[88:89], s[20:21], v[90:91] op_sel_hi:[1,0,1]
    v_pk_fma_f32 v[32:33], v[92:93], s[20:21], v[32:33] op_sel_hi:[1,0,1]
    v_pk_add_f32 v[4:5], v[4:5], v[12:13]
    v_pk_add_f32 v[4:5], v[4:5], v[32:33]
    v_lshlrev_b32 v88, 16, v14
    v_and_b32 v89, s22, v14
    v_lshlrev_b32 v90, 16, v34
    v_and_b32 v91, s22, v34
    v_lshlrev_b32 v92, 16, v15
    v_and_b32 v93, s22, v15
    v_lshlrev_b32 v34, 16, v35
    v_and_b32 v35, s22, v35
    v_pk_fma_f32 v[14:15], v[88:89], s[20:21], v[90:91] op_sel_hi:[1,0,1]
    v_pk_fma_f32 v[34:35], v[92:93], s[20:21], v[34:35] op_sel_hi:[1,0,1]
    v_pk_add_f32 v[4:5], v[4:5], v[14:15]
    v_pk_add_f32 v[4:5], v[4:5], v[34:35]
    s_waitcnt vmcnt(2)
    v_lshlrev_b32 v88, 16, v16
    v_and_b32 v89, s22, v16
    v_lshlrev_b32 v90, 16, v36
    v_and_b32 v91, s22, v36
    v_lshlrev_b32 v92, 16, v17
    v_and_b32 v93, s22, v17
    v_lshlrev_b32 v36, 16, v37
    v_and_b32 v37, s22, v37
    v_pk_fma_f32 v[16:17], v[88:89], s[20:21], v[90:91] op_sel_hi:[1,0,1]
    v_pk_fma_f32 v[36:37], v[92:93], s[20:21], v[36:37] op_sel_hi:[1,0,1]
    v_pk_add_f32 v[4:5], v[4:5], v[16:17]
    v_pk_add_f32 v[4:5], v[4:5], v[36:37]
    v_lshlrev_b32 v88, 16, v18
    v_and_b32 v89, s22, v18
    v_lshlrev_b32 v90, 16, v38
    v_and_b32 v91, s22, v38
    v_lshlrev_b32 v92, 16, v19
    v_and_b32 v93, s22, v19
    v_lshlrev_b32 v38, 16, v39
    v_and_b32 v39, s22, v39
    v_pk_fma_f32 v[18:19], v[88:89], s[20:21], v[90:91] op_sel_hi:[1,0,1]
    v_pk_fma_f32 v[38:39], v[92:93], s[20:21], v[38:39] op_sel_hi:[1,0,1]
    v_pk_add_f32 v[4:5], v[4:5], v[18:19]
    v_pk_add_f32 v[4:5], v[4:5], v[38:39]
    s_waitcnt vmcnt(1)
    v_lshlrev_b32 v88, 16, v20
    v_and_b32 v89, s22, v20
    v_lshlrev_b32 v90, 16, v40
    v_and_b32 v91, s22, v40
    v_lshlrev_b32 v92, 16, v21
    v_and_b32 v93, s22, v21
    v_lshlrev_b32 v40, 16, v41
    v_and_b32 v41, s22, v41
    v_pk_fma_f32 v[20:21], v[88:89], s[20:21], v[90:91] op_sel_hi:[1,0,1]
    v_pk_fma_f32 v[40:41], v[92:93], s[20:21], v[40:41] op_sel_hi:[1,0,1]
    v_pk_add_f32 v[4:5], v[4:5], v[20:21]
    v_pk_add_f32 v[4:5], v[4:5], v[40:41]
    v_lshlrev_b32 v88, 16, v22
    v_and_b32 v89, s22, v22
    v_lshlrev_b32 v90, 16, v42
    v_and_b32 v91, s22, v42
    v_lshlrev_b32 v92, 16, v23
    v_and_b32 v93, s22, v23
    v_lshlrev_b32 v42, 16, v43
    v_and_b32 v43, s22, v43
    v_pk_fma_f32 v[22:23], v[88:89], s[20:21], v[90:91] op_sel_hi:[1,0,1]
    v_pk_fma_f32 v[42:43], v[92:93], s[20:21], v[42:43] op_sel_hi:[1,0,1]
    v_pk_add_f32 v[4:5], v[4:5], v[22:23]
    v_pk_add_f32 v[4:5], v[4:5], v[42:43]
    s_waitcnt vmcnt(0)
    v_lshlrev_b32 v88, 16, v24
    v_and_b32 v89, s22, v24
    v_lshlrev_b32 v90, 16, v44
    v_and_b32 v91, s22, v44
    v_lshlrev_b32 v92, 16, v25
    v_and_b32 v93, s22, v25
    v_lshlrev_b32 v44, 16, v45
    v_and_b32 v45, s22, v45
    v_pk_fma_f32 v[24:25], v[88:89], s[20:21], v[90:91] op_sel_hi:[1,0,1]
    v_pk_fma_f32 v[44:45], v[92:93], s[20:21], v[44:45] op_sel_hi:[1,0,1]
    v_pk_add_f32 v[4:5], v[4:5], v[24:25]
    v_pk_add_f32 v[4:5], v[4:5], v[44:45]
    v_lshlrev_b32 v88, 16, v26
    v_and_b32 v89, s22, v26
    v_lshlrev_b32 v90, 16, v46
    v_and_b32 v91, s22, v46
    v_lshlrev_b32 v92, 16, v27
    v_and_b32 v93, s22, v27
    v_lshlrev_b32 v46, 16, v47
    v_and_b32 v47, s22, v47
    v_pk_fma_f32 v[26:27], v[88:89], s[20:21], v[90:91] op_sel_hi:[1,0,1]
    v_pk_fma_f32 v[46:47], v[92:93], s[20:21], v[46:47] op_sel_hi:[1,0,1]
    v_pk_add_f32 v[4:5], v[4:5], v[26:27]
    v_pk_add_f32 v[4:5], v[4:5], v[46:47]
    v_add_f32 v4, v4, v5
    ds_read_b128 v[88:91], v2 offset:0
    ds_read_b128 v[96:99], v2 offset:2560
    v_add_f32_dpp v4, v4, v4 row_ror:8 row_mask:0xf bank_mask:0xf
    ds_read_b128 v[92:95], v2 offset:256
    ds_read_b128 v[100:103], v2 offset:2816
    v_add_f32_dpp v4, v4, v4 row_ror:4 row_mask:0xf bank_mask:0xf
    ds_read_b128 v[104:107], v2 offset:512
    ds_read_b128 v[112:115], v2 offset:3072
    v_add_f32_dpp v4, v4, v4 row_ror:2 row_mask:0xf bank_mask:0xf
    ds_read_b128 v[108:111], v2 offset:768
    ds_read_b128 v[116:119], v2 offset:3328
    v_add_f32_dpp v4, v4, v4 row_ror:1 row_mask:0xf bank_mask:0xf
    v_mul_f32 v4, 0x3acccccd, v4
    v_pk_add_f32 v[8:9], v[8:9], v[4:5] op_sel_hi:[1,0] neg_lo:[0,1] neg_hi:[0,1]
    v_pk_mul_f32 v[6:7], v[8:9], v[8:9]
    v_pk_add_f32 v[28:29], v[28:29], v[4:5] op_sel_hi:[1,0] neg_lo:[0,1] neg_hi:[0,1]
    v_pk_fma_f32 v[6:7], v[28:29], v[28:29], v[6:7]
    v_pk_add_f32 v[10:11], v[10:11], v[4:5] op_sel_hi:[1,0] neg_lo:[0,1] neg_hi:[0,1]
    v_pk_fma_f32 v[6:7], v[10:11], v[10:11], v[6:7]
    s_branch L_over
L_tramp:
    s_branch L_wait
L_over:
    v_pk_add_f32 v[30:31], v[30:31], v[4:5] op_sel_hi:[1,0] neg_lo:[0,1] neg_hi:[0,1]
    v_pk_fma_f32 v[6:7], v[30:31], v[30:31], v[6:7]
    v_pk_add_f32 v[12:13], v[12:13], v[4:5] op_sel_hi:[1,0] neg_lo:[0,1] neg_hi:[0,1]
    v_pk_fma_f32 v[6:7], v[12:13], v[12:13], v[6:7]
    v_pk_add_f32 v[32:33], v[32:33], v[4:5] op_sel_hi:[1,0] neg_lo:[0,1] neg_hi:[0,1]
    v_pk_fma_f32 v[6:7], v[32:33], v[32:33], v[6:7]
    v_pk_add_f32 v[14:15], v[14:15], v[4:5] op_sel_hi:[1,0] neg_lo:[0,1] neg_hi:[0,1]
    v_pk_fma_f32 v[6:7], v[14:15], v[14:15], v[6:7]
    v_pk_add_f32 v[34:35], v[34:35], v[4:5] op_sel_hi:[1,0] neg_lo:[0,1] neg_hi:[0,1]
    v_pk_fma_f32 v[6:7], v[34:35], v[34:35], v[6:7]
    v_pk_add_f32 v[16:17], v[16:17], v[4:5] op_sel_hi:[1,0] neg_lo:[0,1] neg_hi:[0,1]
    v_pk_fma_f32 v[6:7], v[16:17], v[16:17], v[6:7]
    v_pk_add_f32 v[36:37], v[36:37], v[4:5] op_sel_hi:[1,0] neg_lo:[0,1] neg_hi:[0,1]
    v_pk_fma_f32 v[6:7], v[36:37], v[36:37], v[6:7]
    v_pk_add_f32 v[18:19], v[18:19], v[4:5] op_sel_hi:[1,0] neg_lo:[0,1] neg_hi:[0,1]
    v_pk_fma_f32 v[6:7], v[18:19], v[18:19], v[6:7]
    v_pk_add_f32 v[38:39], v[38:39], v[4:5] op_sel_hi:[1,0] neg_lo:[0,1] neg_hi:[0,1]
    v_pk_fma_f32 v[6:7], v[38:39], v[38:39], v[6:7]
    v_pk_add_f32 v[20:21], v[20:21], v[4:5] op_sel_hi:[1,0] neg_lo:[0,1] neg_hi:[0,1]
    v_pk_fma_f32 v[6:7], v[20:21], v[20:21], v[6:7]
    v_pk_add_f32 v[40:41], v[40:41], v[4:5] op_sel_hi:[1,0] neg_lo:[0,1] neg_hi:[0,1]
    v_pk_fma_f32 v[6:7], v[40:41], v[40:41], v[6:7]
    v_pk_add_f32 v[22:23], v[22:23], v[4:5] op_sel_hi:[1,0] neg_lo:[0,1] neg_hi:[0,1]
    v_pk_fma_f32 v[6:7], v[22:23], v[22:23], v[6:7]
    v_pk_add_f32 v[42:43], v[42:43], v[4:5] op_sel_hi:[1,0] neg_lo:[0,1] neg_hi:[0,1]
    v_pk_fma_f32 v[6:7], v[42:43], v[42:43], v[6:7]
    v_pk_add_f32 v[24:25], v[24:25], v[4:5] op_sel_hi:[1,0] neg_lo:[0,1] neg_hi:[0,1]
    v_pk_fma_f32 v[6:7], v[24:25], v[24:25], v[6:7]
    v_pk_add_f32 v[44:45], v[44:45], v[4:5] op_sel_hi:[1,0] neg_lo:[0,1] neg_hi:[0,1]
    v_pk_fma_f32 v[6:7], v[44:45], v[44:45], v[6:7]
    v_pk_add_f32 v[26:27], v[26:27], v[4:5] op_sel_hi:[1,0] neg_lo:[0,1] neg_hi:[0,1]
    v_pk_fma_f32 v[6:7], v[26:27], v[26:27], v[6:7]
    v_pk_add_f32 v[46:47], v[46:47], v[4:5] op_sel_hi:[1,0] neg_lo:[0,1] neg_hi:[0,1]
    v_pk_fma_f32 v[6:7], v[46:47], v[46:47], v[6:7]
    v_add_f32 v6, v6, v7
    s_nop 1
    v_add_f32_dpp v6, v6, v6 row_ror:8 row_mask:0xf bank_mask:0xf
    s_nop 1
    v_add_f32_dpp v6, v6, v6 row_ror:4 row_mask:0xf bank_mask:0xf
    s_nop 1
    v_add_f32_dpp v6, v6, v6 row_ror:2 row_mask:0xf bank_mask:0xf
    s_nop 1
    v_add_f32_dpp v6, v6, v6 row_ror:1 row_mask:0xf bank_mask:0xf
    v_mov_b32 v7, 0x3727c5ac
    v_fmac_f32 v7, 0x3acccccd, v6
    v_rsq_f32 v6, v7
    s_waitcnt lgkmcnt(4)
    v_pk_mul_f32 v[8:9], v[8:9], v[6:7] op_sel_hi:[1,0]
    v_pk_mul_f32 v[28:29], v[28:29], v[6:7] op_sel_hi:[1,0]
    v_pk_mul_f32 v[10:11], v[10:11], v[6:7] op_sel_hi:[1,0]
    v_pk_mul_f32 v[30:31], v[30:31], v[6:7] op_sel_hi:[1,0]
    v_pk_fma_f32 v[8:9], v[8:9], v[88:89], v[96:97]
    v_pk_fma_f32 v[28:29], v[28:29], v[90:91], v[98:99]
    v_pk_fma_f32 v[10:11], v[10:11], v[92:93], v[100:101]
    v_pk_fma_f32 v[30:31], v[30:31], v[94:95], v[102:103]
    ds_read_b128 v[88:91], v2 offset:1024
    ds_read_b128 v[96:99], v2 offset:3584
    ds_read_b128 v[92:95], v2 offset:1280
    ds_read_b128 v[100:103], v2 offset:3840
    v_cvt_pk_bf16_f32 v8, v8, v9
    v_cvt_pk_bf16_f32 v9, v28, v29
    v_cvt_pk_bf16_f32 v10, v10, v11
    v_cvt_pk_bf16_f32 v11, v30, v31
    v_pk_mul_f32 v[12:13], v[12:13], v[6:7] op_sel_hi:[1,0]
    v_pk_mul_f32 v[32:33], v[32:33], v[6:7] op_sel_hi:[1,0]
    v_pk_mul_f32 v[14:15], v[14:15], v[6:7] op_sel_hi:[1,0]
    v_pk_mul_f32 v[34:35], v[34:35], v[6:7] op_sel_hi:[1,0]
    s_waitcnt lgkmcnt(4)
    v_pk_fma_f32 v[12:13], v[12:13], v[104:105], v[112:113]
    v_pk_fma_f32 v[32:33], v[32:33], v[106:107], v[114:115]
    v_pk_fma_f32 v[14:15], v[14:15], v[108:109], v[116:117]
    v_pk_fma_f32 v[34:35], v[34:35], v[110:111], v[118:119]
    ds_read_b128 v[104:107], v2 offset:1536
    ds_read_b128 v[112:115], v2 offset:4096
    ds_read_b128 v[108:111], v2 offset:1792
    ds_read_b128 v[116:119], v2 offset:4352
    v_cvt_pk_bf16_f32 v12, v12, v13
    v_cvt_pk_bf16_f32 v13, v32, v33
    v_cvt_pk_bf16_f32 v14, v14, v15
    v_cvt_pk_bf16_f32 v15, v34, v35
    v_pk_mul_f32 v[16:17], v[16:17], v[6:7] op_sel_hi:[1,0]
    v_pk_mul_f32 v[36:37], v[36:37], v[6:7] op_sel_hi:[1,0]
    v_pk_mul_f32 v[18:19], v[18:19], v[6:7] op_sel_hi:[1,0]
    v_pk_mul_f32 v[38:39], v[38:39], v[6:7] op_sel_hi:[1,0]
    s_waitcnt lgkmcnt(4)
    v_pk_fma_f32 v[16:17], v[16:17], v[88:89], v[96:97]
    v_pk_fma_f32 v[36:37], v[36:37], v[90:91], v[98:99]
    v_pk_fma_f32 v[18:19], v[18:19], v[92:93], v[100:101]
    v_pk_fma_f32 v[38:39], v[38:39], v[94:95], v[102:103]
    ds_read_b128 v[88:91], v2 offset:2048
    ds_read_b128 v[96:99], v2 offset:4608
    ds_read_b128 v[92:95], v2 offset:2304
    ds_read_b128 v[100:103], v2 offset:4864
    v_cvt_pk_bf16_f32 v16, v16, v17
    v_cvt_pk_bf16_f32 v17, v36, v37
    v_cvt_pk_bf16_f32 v18, v18, v19
    v_cvt_pk_bf16_f32 v19, v38, v39
    v_pk_mul_f32 v[20:21], v[20:21], v[6:7] op_sel_hi:[1,0]
    v_pk_mul_f32 v[40:41], v[40:41], v[6:7] op_sel_hi:[1,0]
    v_pk_mul_f32 v[22:23], v[22:23], v[6:7] op_sel_hi:[1,0]
    v_pk_mul_f32 v[42:43], v[42:43], v[6:7] op_sel_hi:[1,0]
    s_waitcnt lgkmcnt(4)
    v_pk_fma_f32 v[20:21], v[20:21], v[104:105], v[112:113]
    v_pk_fma_f32 v[40:41], v[40:41], v[106:107], v[114:115]
    v_pk_fma_f32 v[22:23], v[22:23], v[108:109], v[116:117]
    v_pk_fma_f32 v[42:43], v[42:43], v[110:111], v[118:119]
    v_cvt_pk_bf16_f32 v20, v20, v21
    v_cvt_pk_bf16_f32 v21, v40, v41
    v_cvt_pk_bf16_f32 v22, v22, v23
    v_cvt_pk_bf16_f32 v23, v42, v43
    v_pk_mul_f32 v[24:25], v[24:25], v[6:7] op_sel_hi:[1,0]
    v_pk_mul_f32 v[44:45], v[44:45], v[6:7] op_sel_hi:[1,0]
    v_pk_mul_f32 v[26:27], v[26:27], v[6:7] op_sel_hi:[1,0]
    v_pk_mul_f32 v[46:47], v[46:47], v[6:7] op_sel_hi:[1,0]
    s_waitcnt lgkmcnt(0)
    v_pk_fma_f32 v[24:25], v[24:25], v[88:89], v[96:97]
    v_pk_fma_f32 v[44:45], v[44:45], v[90:91], v[98:99]
    v_pk_fma_f32 v[26:27], v[26:27], v[92:93], v[100:101]
    v_pk_fma_f32 v[46:47], v[46:47], v[94:95], v[102:103]
    v_cvt_pk_bf16_f32 v24, v24, v25
    v_cvt_pk_bf16_f32 v25, v44, v45
    v_cvt_pk_bf16_f32 v26, v26, v27
    v_cvt_pk_bf16_f32 v27, v46, v47
    s_cbranch_scc0 L_last4
    s_cmp_eq_u32 s24, 1
    s_cbranch_scc1 L_swap
    s_cmp_eq_u32 s24, 2
    s_barrier
    global_store_dwordx4 v1, v[8:11], s[14:15] offset:0 nt
    global_store_dwordx4 v1, v[12:15], s[14:15] offset:256 nt
    global_store_dwordx4 v1, v[16:19], s[14:15] offset:512 nt
    global_store_dwordx4 v1, v[20:23], s[14:15] offset:768 nt
    global_store_dwordx4 v1, v[24:27], s[14:15] offset:1024 nt
    s_cbranch_scc0 L_end
    s_mov_b64 exec, s[28:29]
    global_store_dwordx4 v3, v[48:51], s[14:15] offset:0 nt
    global_store_dwordx4 v3, v[52:55], s[14:15] offset:256 nt
    global_store_dwordx4 v3, v[56:59], s[14:15] offset:512 nt
    global_store_dwordx4 v3, v[60:63], s[14:15] offset:768 nt
    global_store_dwordx4 v3, v[64:67], s[14:15] offset:1024 nt
L_end:
    s_endpgm
L_wait:
    s_bitcmp1_b32 s2, 0
    s_cselect_b32 s26, 32, 0
    v_subrev_u32 v7, 352, v0
    v_cmp_le_u32 vcc, s26, v7
    s_mov_b64 exec, vcc
    s_xor_b32 s27, s23, 320
    s_or_b32 s27, s27, s26
    s_cbranch_scc0 L_adopt
    s_min_u32 s26, s23, 768
    s_waitcnt lgkmcnt(0)
    s_load_dword s20, s[12:13], 0
L_pre:
    s_sub_u32 s26, s26, 64
    s_cmpk_lt_u32 s26, 0x100
    s_barrier
    s_cbranch_scc1 L_ld
    s_branch L_pre
L_last4:
    global_store_dwordx4 v1, v[8:11], s[14:15] offset:0 nt
    global_store_dwordx4 v1, v[12:15], s[14:15] offset:256 nt
    global_store_dwordx4 v1, v[16:19], s[14:15] offset:512 nt
    global_store_dwordx4 v1, v[20:23], s[14:15] offset:768
    global_store_dwordx4 v1, v[24:27], s[14:15] offset:1024
    s_endpgm
L_stage:
    v_and_b32 v4, 1, v6
    v_lshlrev_b32 v4, 8, v4
    v_lshrrev_b32 v5, 5, v6
    v_lshl_add_u32 v4, v5, 9, v4
    v_and_b32 v3, 0xf0, v3
    v_add_u32 v3, v3, v4
    v_cmp_gt_u32 vcc, 0xa0, v0
    s_waitcnt vmcnt(10)
    v_lshlrev_b32 v88, 16, v48
    v_and_b32 v89, s22, v48
    v_lshlrev_b32 v90, 16, v49
    v_and_b32 v91, s22, v49
    v_lshlrev_b32 v92, 16, v50
    v_and_b32 v93, s22, v50
    v_lshlrev_b32 v94, 16, v51
    v_and_b32 v95, s22, v51
    s_mov_b64 exec, vcc
    ds_write_b128 v3, v[88:91]
    ds_write_b128 v3, v[92:95] offset:2560
    s_mov_b64 exec, -1
    s_waitcnt lgkmcnt(0)
    s_barrier
    s_branch L_staged
L_adopt:
    s_mov_b32 s24, 1
    s_lshr_b64 s[28:29], -1, 32
    s_not_b64 s[28:29], s[28:29]
    v_add_u32 v3, 5120, v1
    v_cndmask_b32 v6, 2.0, v3, s[28:29]
    s_mov_b32 s34, 20971520
    s_mov_b32 s35, 0x20000
    s_mov_b32 s38, 20971520
    s_mov_b32 s39, 0x20000
    s_waitcnt lgkmcnt(0)
    s_load_dword s20, s[12:13], 0
    s_mov_b64 s[32:33], s[4:5]
    s_mov_b64 s[36:37], s[6:7]
    s_barrier
    s_barrier
    buffer_load_dwordx4 v[48:51], v1, s[32:35], 0 offen offset:0 nt
    buffer_load_dwordx4 v[52:55], v1, s[32:35], 0 offen offset:256 nt
    buffer_load_dwordx4 v[56:59], v1, s[32:35], 0 offen offset:512 nt
    buffer_load_dwordx4 v[60:63], v1, s[32:35], 0 offen offset:768 nt
    buffer_load_dwordx4 v[64:67], v1, s[32:35], 0 offen offset:1024 nt
    buffer_load_dwordx4 v[68:71], v1, s[36:39], 0 offen offset:0 nt
    buffer_load_dwordx4 v[72:75], v1, s[36:39], 0 offen offset:256 nt
    buffer_load_dwordx4 v[76:79], v1, s[36:39], 0 offen offset:512 nt
    buffer_load_dwordx4 v[80:83], v1, s[36:39], 0 offen offset:768 nt
    buffer_load_dwordx4 v[84:87], v1, s[36:39], 0 offen offset:1024 nt
    buffer_load_dwordx4 v[8:11], v6, s[32:35], 0 offen offset:0 nt
    buffer_load_dwordx4 v[12:15], v6, s[32:35], 0 offen offset:256 nt
    buffer_load_dwordx4 v[16:19], v6, s[32:35], 0 offen offset:512 nt
    buffer_load_dwordx4 v[20:23], v6, s[32:35], 0 offen offset:768 nt
    buffer_load_dwordx4 v[24:27], v6, s[32:35], 0 offen offset:1024 nt
    buffer_load_dwordx4 v[28:31], v6, s[36:39], 0 offen offset:0 nt
    buffer_load_dwordx4 v[32:35], v6, s[36:39], 0 offen offset:256 nt
    buffer_load_dwordx4 v[36:39], v6, s[36:39], 0 offen offset:512 nt
    buffer_load_dwordx4 v[40:43], v6, s[36:39], 0 offen offset:768 nt
    buffer_load_dwordx4 v[44:47], v6, s[36:39], 0 offen offset:1024 nt
    s_branch L_ldone
L_swap:
    s_mov_b32 s24, 2
    v_swap_b32 v8, v48
    v_swap_b32 v9, v49
    v_swap_b32 v10, v50
    v_swap_b32 v11, v51
    v_swap_b32 v12, v52
    v_swap_b32 v13, v53
    v_swap_b32 v14, v54
    v_swap_b32 v15, v55
    v_swap_b32 v16, v56
    v_swap_b32 v17, v57
    v_swap_b32 v18, v58
    v_swap_b32 v19, v59
    v_swap_b32 v20, v60
    v_swap_b32 v21, v61
    v_swap_b32 v22, v62
    v_swap_b32 v23, v63
    v_swap_b32 v24, v64
    v_swap_b32 v25, v65
    v_swap_b32 v26, v66
    v_swap_b32 v27, v67
    v_mov_b32 v28, v68
    v_mov_b32 v29, v69
    v_mov_b32 v30, v70
    v_mov_b32 v31, v71
    v_mov_b32 v32, v72
    v_mov_b32 v33, v73
    v_mov_b32 v34, v74
    v_mov_b32 v35, v75
    v_mov_b32 v36, v76
    v_mov_b32 v37, v77
    v_mov_b32 v38, v78
    v_mov_b32 v39, v79
    v_mov_b32 v40, v80
    v_mov_b32 v41, v81
    v_mov_b32 v42, v82
    v_mov_b32 v43, v83
    v_mov_b32 v44, v84
    v_mov_b32 v45, v85
    v_mov_b32 v46, v86
    v_mov_b32 v47, v87
    s_branch L_pass
.section .rodata,"a"
.p2align 6
.amdhsa_kernel standalone__deepnorm__sampling_kernel
  .amdhsa_next_free_vgpr 120
  .amdhsa_next_free_sgpr 40
  .amdhsa_accum_offset 120
  .amdhsa_group_segment_fixed_size 0
  .amdhsa_kernarg_size 64
  .amdhsa_user_sgpr_count 2
  .amdhsa_user_sgpr_kernarg_segment_ptr 1
  .amdhsa_system_sgpr_workgroup_id_x 1
  .amdhsa_float_denorm_mode_32 3
.end_amdhsa_kernel
```
